```python
import torch

def _softmax(x, axis=-1):
    return torch.softmax(x, dim=axis)
def _gelu(x):
    return torch.nn.functional.gelu(x, approximate="tanh")
def _silu(x):
    return torch.nn.functional.silu(x)
def _sigmoid(x):
    return torch.sigmoid(x)
def _layernorm(x, axis=-1, eps=1e-5):
    m = x.mean(dim=axis, keepdim=True)
    v = x.var(dim=axis, keepdim=True, unbiased=False)
    return (x - m) / torch.sqrt(v + eps)
def _scatter_add(tgt, idx, src, axis=0):
    return tgt.clone().index_add_(axis, idx, src)
def _segment_sum(src, seg, n):
    out = torch.zeros((n,) + src.shape[1:], dtype=src.dtype)
    return out.index_add_(0, seg, src)
def _pad(x, pw):
    flat = tuple(v for pair in reversed(pw) for v in pair)
    return torch.nn.functional.pad(x, flat)

kernel_name = 'standalone__instancenorm__sampling'

def setup_inputs():

    _w = (lambda a: (lambda t: t.to(torch.bfloat16) if t.is_floating_point() else t)(torch.as_tensor(a)))
    B, C, H, W = 32, 576, 16, 32
    return {
        "x": _w(abs((lambda *s: torch.randn(*s, dtype=torch.bfloat16) * 0.05)(B, C, H, W))),
        "g": _w((lambda *s: torch.randn(*s, dtype=torch.bfloat16) * 0.05)(C) + 1.0),
        "b": _w((lambda *s: torch.randn(*s, dtype=torch.bfloat16) * 0.4)(C)),
    }

def reference(x, g, b):
    mu = x.mean(axis=(-2, -1), keepdims=True)
    var = ((x - mu) ** 2).mean(axis=(-2, -1), keepdims=True)
    xhat = (x - mu) / torch.sqrt(var + 1e-5)
    return xhat * g.reshape(1, -1, 1, 1) + b.reshape(1, -1, 1, 1)
```

```asm
; @launch grid=(256,1,1) block=(384,1,1) lds=0
.amdgcn_target "amdgcn-amd-amdhsa--gfx950"
.text
.globl standalone__instancenorm__sampling_kernel
.p2align 12
.p2align 8
.type standalone__instancenorm__sampling_kernel,@function
standalone__instancenorm__sampling_kernel:
    s_load_dwordx8 s[4:11], s[0:1], 0
    s_cmp_ge_u32 s2, 256
    s_cbranch_scc1 L_end
    v_readfirstlane_b32 s22, v0
    v_lshrrev_b32 v1, 4, v0
    v_lshlrev_b32 v2, 4, v0
    v_mul_u32_u24 v3, 768, v1
    s_mul_i32 s12, s2, 73728
    v_and_b32 v1, 48, v0
    v_add3_u32 v0, v2, v3, s12
    v_add_u32 v10, 24576, v0
    v_add_u32 v11, 49152, v0
    s_and_b32 s13, s2, 7
    s_mul_i32 s13, s13, 144
    s_lshr_b32 s19, s22, 3
    s_add_u32 s13, s13, s19
    s_mov_b32 s14, 0x3f803f80
    s_movk_i32 s15, 0x3f80
    s_mov_b32 s16, 1.0
    s_mov_b32 s17, 0xbb000000
    s_mov_b32 s18, 0x3b000000
    s_mov_b32 s20, 0x3727c5ac
    s_mov_b32 s21, 0
    s_waitcnt lgkmcnt(0)
    global_load_dwordx4 v[12:15], v0, s[4:5] offset:0 nt
    global_load_dwordx4 v[16:19], v0, s[4:5] offset:256 nt
    global_load_dwordx4 v[20:23], v0, s[4:5] offset:512 nt
    global_load_dwordx4 v[24:27], v0, s[4:5] offset:768 nt
    s_add_u32 s6, s6, s13
    s_addc_u32 s7, s7, 0
    s_add_u32 s8, s8, s13
    s_addc_u32 s9, s9, 0
    s_load_dwordx2 s[24:25], s[6:7], 0
    s_load_dwordx2 s[26:27], s[8:9], 0
    s_load_dwordx2 s[28:29], s[6:7], 48
    s_load_dwordx2 s[30:31], s[8:9], 48
    s_load_dwordx2 s[32:33], s[6:7], 96
    s_load_dwordx2 s[34:35], s[8:9], 96
    s_waitcnt vmcnt(0)
    global_load_dwordx4 v[28:31], v10, s[4:5] offset:0 nt
    global_load_dwordx4 v[32:35], v10, s[4:5] offset:256 nt
    global_load_dwordx4 v[36:39], v10, s[4:5] offset:512 nt
    global_load_dwordx4 v[40:43], v10, s[4:5] offset:768 nt
L_comp:
    v_mov_b32 v2, 0
    v_mov_b32 v3, 0
    v_dot2c_f32_bf16 v2, s14, v12
    v_dot2c_f32_bf16 v3, s14, v13
    v_dot2c_f32_bf16 v2, s14, v14
    v_dot2c_f32_bf16 v3, s14, v15
    v_dot2c_f32_bf16 v2, s14, v16
    v_dot2c_f32_bf16 v3, s14, v17
    v_dot2c_f32_bf16 v2, s14, v18
    v_dot2c_f32_bf16 v3, s14, v19
    v_dot2c_f32_bf16 v2, s14, v20
    v_dot2c_f32_bf16 v3, s14, v21
    v_dot2c_f32_bf16 v2, s14, v22
    v_dot2c_f32_bf16 v3, s14, v23
    v_dot2c_f32_bf16 v2, s14, v24
    v_dot2c_f32_bf16 v3, s14, v25
    v_dot2c_f32_bf16 v2, s14, v26
    v_dot2c_f32_bf16 v3, s14, v27
    s_nop 2
    v_add_f32 v2, v2, v3
    s_nop 1
    v_add_f32_dpp v2, v2, v2 row_ror:8 row_mask:0xf bank_mask:0xf
    s_nop 1
    v_add_f32_dpp v2, v2, v2 row_ror:4 row_mask:0xf bank_mask:0xf
    s_nop 1
    v_add_f32_dpp v2, v2, v2 row_ror:2 row_mask:0xf bank_mask:0xf
    s_nop 1
    v_add_f32_dpp v2, v2, v2 row_ror:1 row_mask:0xf bank_mask:0xf
    v_mul_f32 v2, s17, v2
    v_cvt_pk_bf16_f32 v2, v2, v2
    v_lshlrev_b32 v2, 16, v2
    v_dot2_f32_bf16 v76, v12, s15, v2
    v_dot2_f32_bf16 v77, v12, s16, v2
    v_dot2_f32_bf16 v78, v13, s15, v2
    v_dot2_f32_bf16 v79, v13, s16, v2
    v_dot2_f32_bf16 v80, v14, s15, v2
    v_dot2_f32_bf16 v81, v14, s16, v2
    v_dot2_f32_bf16 v82, v15, s15, v2
    v_dot2_f32_bf16 v83, v15, s16, v2
    v_dot2_f32_bf16 v84, v16, s15, v2
    v_dot2_f32_bf16 v85, v16, s16, v2
    v_dot2_f32_bf16 v86, v17, s15, v2
    v_dot2_f32_bf16 v87, v17, s16, v2
    v_dot2_f32_bf16 v88, v18, s15, v2
    v_dot2_f32_bf16 v89, v18, s16, v2
    v_dot2_f32_bf16 v90, v19, s15, v2
    v_dot2_f32_bf16 v91, v19, s16, v2
    v_dot2_f32_bf16 v92, v20, s15, v2
    v_dot2_f32_bf16 v93, v20, s16, v2
    v_dot2_f32_bf16 v94, v21, s15, v2
    v_dot2_f32_bf16 v95, v21, s16, v2
    v_dot2_f32_bf16 v96, v22, s15, v2
    v_dot2_f32_bf16 v97, v22, s16, v2
    v_dot2_f32_bf16 v98, v23, s15, v2
    v_dot2_f32_bf16 v99, v23, s16, v2
    v_dot2_f32_bf16 v100, v24, s15, v2
    v_dot2_f32_bf16 v101, v24, s16, v2
    v_dot2_f32_bf16 v102, v25, s15, v2
    v_dot2_f32_bf16 v103, v25, s16, v2
    v_dot2_f32_bf16 v104, v26, s15, v2
    v_dot2_f32_bf16 v105, v26, s16, v2
    v_dot2_f32_bf16 v106, v27, s15, v2
    v_dot2_f32_bf16 v107, v27, s16, v2
    v_pk_mul_f32 v[2:3], v[76:77], v[76:77]
    v_pk_mul_f32 v[4:5], v[78:79], v[78:79]
    v_pk_fma_f32 v[2:3], v[80:81], v[80:81], v[2:3]
    v_pk_fma_f32 v[4:5], v[82:83], v[82:83], v[4:5]
    v_pk_fma_f32 v[2:3], v[84:85], v[84:85], v[2:3]
    v_pk_fma_f32 v[4:5], v[86:87], v[86:87], v[4:5]
    v_pk_fma_f32 v[2:3], v[88:89], v[88:89], v[2:3]
    v_pk_fma_f32 v[4:5], v[90:91], v[90:91], v[4:5]
    v_pk_fma_f32 v[2:3], v[92:93], v[92:93], v[2:3]
    v_pk_fma_f32 v[4:5], v[94:95], v[94:95], v[4:5]
    v_pk_fma_f32 v[2:3], v[96:97], v[96:97], v[2:3]
    v_pk_fma_f32 v[4:5], v[98:99], v[98:99], v[4:5]
    v_pk_fma_f32 v[2:3], v[100:101], v[100:101], v[2:3]
    v_pk_fma_f32 v[4:5], v[102:103], v[102:103], v[4:5]
    v_pk_fma_f32 v[2:3], v[104:105], v[104:105], v[2:3]
    v_pk_fma_f32 v[4:5], v[106:107], v[106:107], v[4:5]
    v_pk_add_f32 v[2:3], v[2:3], v[4:5]
    v_add_f32 v2, v2, v3
    s_waitcnt lgkmcnt(0)
    v_lshrrev_b64 v[6:7], v1, s[24:25]
    v_add_f32_dpp v2, v2, v2 row_ror:8 row_mask:0xf bank_mask:0xf
    v_lshrrev_b64 v[8:9], v1, s[26:27]
    v_lshlrev_b32 v6, 16, v6
    v_add_f32_dpp v2, v2, v2 row_ror:4 row_mask:0xf bank_mask:0xf
    v_lshlrev_b32 v7, 16, v8
    s_nop 0
    v_add_f32_dpp v2, v2, v2 row_ror:2 row_mask:0xf bank_mask:0xf
    s_nop 1
    v_add_f32_dpp v2, v2, v2 row_ror:1 row_mask:0xf bank_mask:0xf
    v_mul_f32 v2, s18, v2
    v_cvt_pk_bf16_f32 v2, v2, v2
    v_lshlrev_b32 v2, 16, v2
    v_add_f32 v2, s20, v2
    v_cvt_pk_bf16_f32 v2, v2, v2
    v_lshlrev_b32 v2, 16, v2
    v_sqrt_f32 v2, v2
    s_nop 0
    v_cvt_pk_bf16_f32 v2, v2, v2
    v_lshlrev_b32 v2, 16, v2
    v_rcp_f32 v2, v2
    s_cmp_eq_u32 s21, 1
    v_mul_f32 v6, v6, v2
    v_pk_fma_f32 v[76:77], v[76:77], v[6:7], v[6:7] op_sel:[0,0,1] op_sel_hi:[1,0,1]
    v_pk_fma_f32 v[78:79], v[78:79], v[6:7], v[6:7] op_sel:[0,0,1] op_sel_hi:[1,0,1]
    v_pk_fma_f32 v[80:81], v[80:81], v[6:7], v[6:7] op_sel:[0,0,1] op_sel_hi:[1,0,1]
    v_pk_fma_f32 v[82:83], v[82:83], v[6:7], v[6:7] op_sel:[0,0,1] op_sel_hi:[1,0,1]
    v_pk_fma_f32 v[84:85], v[84:85], v[6:7], v[6:7] op_sel:[0,0,1] op_sel_hi:[1,0,1]
    v_pk_fma_f32 v[86:87], v[86:87], v[6:7], v[6:7] op_sel:[0,0,1] op_sel_hi:[1,0,1]
    v_pk_fma_f32 v[88:89], v[88:89], v[6:7], v[6:7] op_sel:[0,0,1] op_sel_hi:[1,0,1]
    v_pk_fma_f32 v[90:91], v[90:91], v[6:7], v[6:7] op_sel:[0,0,1] op_sel_hi:[1,0,1]
    v_pk_fma_f32 v[92:93], v[92:93], v[6:7], v[6:7] op_sel:[0,0,1] op_sel_hi:[1,0,1]
    v_pk_fma_f32 v[94:95], v[94:95], v[6:7], v[6:7] op_sel:[0,0,1] op_sel_hi:[1,0,1]
    v_pk_fma_f32 v[96:97], v[96:97], v[6:7], v[6:7] op_sel:[0,0,1] op_sel_hi:[1,0,1]
    v_pk_fma_f32 v[98:99], v[98:99], v[6:7], v[6:7] op_sel:[0,0,1] op_sel_hi:[1,0,1]
    v_pk_fma_f32 v[100:101], v[100:101], v[6:7], v[6:7] op_sel:[0,0,1] op_sel_hi:[1,0,1]
    v_pk_fma_f32 v[102:103], v[102:103], v[6:7], v[6:7] op_sel:[0,0,1] op_sel_hi:[1,0,1]
    v_pk_fma_f32 v[104:105], v[104:105], v[6:7], v[6:7] op_sel:[0,0,1] op_sel_hi:[1,0,1]
    v_pk_fma_f32 v[106:107], v[106:107], v[6:7], v[6:7] op_sel:[0,0,1] op_sel_hi:[1,0,1]
    v_cvt_pk_bf16_f32 v12, v76, v77
    v_cvt_pk_bf16_f32 v13, v78, v79
    v_cvt_pk_bf16_f32 v14, v80, v81
    v_cvt_pk_bf16_f32 v15, v82, v83
    v_cvt_pk_bf16_f32 v16, v84, v85
    v_cvt_pk_bf16_f32 v17, v86, v87
    v_cvt_pk_bf16_f32 v18, v88, v89
    v_cvt_pk_bf16_f32 v19, v90, v91
    v_cvt_pk_bf16_f32 v20, v92, v93
    v_cvt_pk_bf16_f32 v21, v94, v95
    v_cvt_pk_bf16_f32 v22, v96, v97
    v_cvt_pk_bf16_f32 v23, v98, v99
    v_cvt_pk_bf16_f32 v24, v100, v101
    v_cvt_pk_bf16_f32 v25, v102, v103
    v_cvt_pk_bf16_f32 v26, v104, v105
    v_cvt_pk_bf16_f32 v27, v106, v107
    s_cbranch_scc1 L_ph1
    s_cmp_eq_u32 s21, 2
    s_cbranch_scc1 L_ph2
    s_mov_b32 s21, 1
    s_mov_b64 s[24:25], s[28:29]
    s_mov_b64 s[26:27], s[30:31]
    v_mov_b64 v[60:61], v[12:13]
    v_mov_b64 v[62:63], v[14:15]
    v_mov_b64 v[64:65], v[16:17]
    v_mov_b64 v[66:67], v[18:19]
    v_mov_b64 v[68:69], v[20:21]
    v_mov_b64 v[70:71], v[22:23]
    v_mov_b64 v[72:73], v[24:25]
    v_mov_b64 v[74:75], v[26:27]
    s_waitcnt vmcnt(0)
    global_store_dwordx4 v0, v[60:63], s[10:11] offset:0
    global_load_dwordx4 v[44:47], v11, s[4:5] offset:0 nt
    global_load_dwordx4 v[48:51], v11, s[4:5] offset:256 nt
    global_load_dwordx4 v[52:55], v11, s[4:5] offset:512 nt
    global_load_dwordx4 v[56:59], v11, s[4:5] offset:768 nt
    v_mov_b64 v[12:13], v[28:29]
    v_mov_b64 v[14:15], v[30:31]
    v_mov_b64 v[16:17], v[32:33]
    v_mov_b64 v[18:19], v[34:35]
    v_mov_b64 v[20:21], v[36:37]
    v_mov_b64 v[22:23], v[38:39]
    v_mov_b64 v[24:25], v[40:41]
    v_mov_b64 v[26:27], v[42:43]
    s_branch L_comp
L_ph1:
    s_mov_b32 s21, 2
    s_mov_b64 s[24:25], s[32:33]
    s_mov_b64 s[26:27], s[34:35]
    v_mov_b64 v[28:29], v[12:13]
    v_mov_b64 v[30:31], v[14:15]
    v_mov_b64 v[32:33], v[16:17]
    v_mov_b64 v[34:35], v[18:19]
    v_mov_b64 v[36:37], v[20:21]
    v_mov_b64 v[38:39], v[22:23]
    v_mov_b64 v[40:41], v[24:25]
    v_mov_b64 v[42:43], v[26:27]
    s_waitcnt vmcnt(0)
    v_mov_b64 v[12:13], v[44:45]
    v_mov_b64 v[14:15], v[46:47]
    v_mov_b64 v[16:17], v[48:49]
    v_mov_b64 v[18:19], v[50:51]
    v_mov_b64 v[20:21], v[52:53]
    v_mov_b64 v[22:23], v[54:55]
    v_mov_b64 v[24:25], v[56:57]
    v_mov_b64 v[26:27], v[58:59]
    s_branch L_comp
L_ph2:
    global_store_dwordx4 v0, v[64:67], s[10:11] offset:256 nt
    global_store_dwordx4 v0, v[68:71], s[10:11] offset:512 nt
    global_store_dwordx4 v0, v[72:75], s[10:11] offset:768 nt
    global_store_dwordx4 v10, v[28:31], s[10:11] offset:0 nt
    global_store_dwordx4 v10, v[32:35], s[10:11] offset:256 nt
    global_store_dwordx4 v10, v[36:39], s[10:11] offset:512 nt
    global_store_dwordx4 v10, v[40:43], s[10:11] offset:768 nt
    global_store_dwordx4 v11, v[12:15], s[10:11] offset:0 nt
    global_store_dwordx4 v11, v[16:19], s[10:11] offset:256 nt
    global_store_dwordx4 v11, v[20:23], s[10:11] offset:512 nt
    global_store_dwordx4 v11, v[24:27], s[10:11] offset:768 nt
L_end:
    s_endpgm
.section .rodata,"a"
.p2align 6
.amdhsa_kernel standalone__instancenorm__sampling_kernel
  .amdhsa_next_free_vgpr 108
  .amdhsa_next_free_sgpr 36
  .amdhsa_accum_offset 108
  .amdhsa_group_segment_fixed_size 0
  .amdhsa_kernarg_size 48
  .amdhsa_user_sgpr_count 2
  .amdhsa_user_sgpr_kernarg_segment_ptr 1
  .amdhsa_system_sgpr_workgroup_id_x 1
.end_amdhsa_kernel
```
